```python
import torch

def _softmax(x, axis=-1):
    return torch.softmax(x, dim=axis)
def _gelu(x):
    return torch.nn.functional.gelu(x, approximate="tanh")
def _silu(x):
    return torch.nn.functional.silu(x)
def _sigmoid(x):
    return torch.sigmoid(x)
def _layernorm(x, axis=-1, eps=1e-5):
    m = x.mean(dim=axis, keepdim=True)
    v = x.var(dim=axis, keepdim=True, unbiased=False)
    return (x - m) / torch.sqrt(v + eps)
def _scatter_add(tgt, idx, src, axis=0):
    return tgt.clone().index_add_(axis, idx, src)
def _segment_sum(src, seg, n):
    out = torch.zeros((n,) + src.shape[1:], dtype=src.dtype)
    return out.index_add_(0, seg, src)
def _pad(x, pw):
    flat = tuple(v for pair in reversed(pw) for v in pair)
    return torch.nn.functional.pad(x, flat)

kernel_name = 'standalone__gqa_softmax__decode'

def setup_inputs():

    _w = (lambda a: (lambda t: t.to(torch.bfloat16) if t.is_floating_point() else t)(torch.as_tensor(a)))
    B, Hq, Hkv, Sq, Sk, D = 4, 32, 16, 1, 4096, 128
    return {
        "q": _w((lambda *s: torch.randn(*s, dtype=torch.bfloat16) * 0.8)(B, Hq, Sq, D)),
        "k": _w((lambda *s: torch.randn(*s, dtype=torch.bfloat16) * 0.8)(B, Hkv, Sk, D)),
        "v": _w((lambda *s: torch.randn(*s, dtype=torch.bfloat16) * 0.05)(B, Hkv, Sk, D)),
    }

def reference(q, k, v):
    B, Hq, Sq, D = q.shape
    Hkv = k.shape[1]
    rep = Hq // Hkv
    k = (lambda x, n, axis: torch.repeat_interleave(x, n, dim=axis))(k, rep, axis=1)
    v = (lambda x, n, axis: torch.repeat_interleave(x, n, dim=axis))(v, rep, axis=1)
    scale = D ** -0.5
    scores = torch.einsum("bhqd,bhkd->bhqk", q, k) * scale
    p = _softmax(scores, axis=-1)
    return torch.einsum("bhqk,bhkd->bhqd", p, v)
```

```asm
; @launch grid=(256,1,1) block=(320,1,1) lds=83968
.amdgcn_target "amdgcn-amd-amdhsa--gfx950"
.text
.globl standalone__gqa_softmax__decode_kernel
.p2align 8
.type standalone__gqa_softmax__decode_kernel,@function
standalone__gqa_softmax__decode_kernel:
    s_cmp_ge_u32 s2, 256
    s_cbranch_scc1 L_end
    s_load_dwordx2 s[16:17], s[0:1], 8
    s_load_dwordx2 s[20:21], s[0:1], 16
    s_load_dwordx2 s[24:25], s[0:1], 0
    s_load_dwordx2 s[28:29], s[0:1], 24
    s_load_dwordx2 s[36:37], s[0:1], 32
    s_load_dwordx2 s[32:33], s[0:1], 40
    v_lshrrev_b32 v19, 6, v0
    v_and_b32 v1, 63, v0
    v_readfirstlane_b32 s42, v19
    s_and_b32 s44, s2, 7
    s_lshr_b32 s45, s2, 3
    s_lshr_b32 s41, s44, 1
    s_xor_b32 s40, s44, s41
    s_and_b32 s40, s40, 1
    s_lshl_b32 s40, s40, 1
    s_and_b32 s41, s41, 1
    s_and_b32 s47, s44, 4
    s_or_b32 s47, s47, s40
    s_or_b32 s47, s47, s41
    s_lshr_b32 s41, s44, 2
    s_mul_i32 s40, s41, 5
    s_xor_b32 s40, s40, s44
    s_lshl_b32 s40, s40, 1
    s_or_b32 s40, s40, s41
    s_bitcmp1_b32 s45, 1
    s_cselect_b32 s44, s40, s47
    s_and_b32 s41, s44, 1
    s_lshl_b32 s41, s41, 1
    s_and_b32 s40, s45, 1
    s_or_b32 s41, s41, s40
    s_lshr_b32 s44, s44, 1
    s_lshl_b32 s44, s44, 4
    s_lshr_b32 s45, s45, 1
    s_add_u32 s40, s44, s45
    v_and_b32 v2, 3, v1
    v_lshlrev_b32 v2, 4, v2
    v_lshrrev_b32 v18, 4, v1
    v_lshl_add_u32 v2, v18, 6, v2
    v_bfe_u32 v18, v1, 3, 1
    v_lshl_add_u32 v25, v18, 8, v2
    v_bfe_u32 v18, v1, 2, 2
    v_lshl_add_u32 v2, v18, 8, v2
    v_lshlrev_b32 v3, 4, v1
    s_mul_i32 s47, s41, 4
    s_add_u32 s47, s47, s42
    s_lshl_b32 s47, s47, 12
    s_lshl_b32 s44, s40, 20
    s_add_u32 s47, s47, s44
    s_mov_b32 s48, 65536
    s_add_u32 s45, s47, s48
    s_lshl_b32 s44, s40, 9
    s_mov_b32 s18, 0x4000000
    s_mov_b32 s19, 0x20000
    s_mov_b32 s22, 0x4000000
    s_mov_b32 s23, 0x20000
    s_mov_b32 s26, 0x8000
    s_mov_b32 s27, 0x20000
    s_cmp_eq_u32 s42, 4
    s_waitcnt lgkmcnt(0)
    s_cbranch_scc1 L_helper
    buffer_load_dwordx4 v[4:7], v25, s[24:27], s44 offen
    buffer_load_dwordx4 v[56:59], v2, s[16:19], s47 offen nt
    buffer_load_dwordx4 v[60:63], v2, s[16:19], s47 offen offset:1024 nt
    buffer_load_dwordx4 v[64:67], v2, s[16:19], s47 offen offset:2048 nt
    buffer_load_dwordx4 v[68:71], v2, s[16:19], s47 offen offset:3072 nt
    buffer_load_dwordx4 v[72:75], v3, s[20:23], s47 offen nt
    buffer_load_dwordx4 v[76:79], v3, s[20:23], s47 offen offset:1024 nt
    buffer_load_dwordx4 v[80:83], v3, s[20:23], s47 offen offset:2048 nt
    buffer_load_dwordx4 v[84:87], v3, s[20:23], s47 offen offset:3072 nt
    s_barrier
    buffer_load_dwordx4 v[88:91], v2, s[16:19], s45 offen nt
    buffer_load_dwordx4 v[92:95], v2, s[16:19], s45 offen offset:1024 nt
    buffer_load_dwordx4 v[96:99], v2, s[16:19], s45 offen offset:2048 nt
    buffer_load_dwordx4 v[100:103], v2, s[16:19], s45 offen offset:3072 nt
    buffer_load_dwordx4 v[104:107], v3, s[20:23], s45 offen nt
    buffer_load_dwordx4 v[108:111], v3, s[20:23], s45 offen offset:1024 nt
    buffer_load_dwordx4 v[112:115], v3, s[20:23], s45 offen offset:2048 nt
    buffer_load_dwordx4 v[116:119], v3, s[20:23], s45 offen offset:3072 nt
    s_add_u32 s47, s45, s48
    s_mov_b32 s43, 0x3e0293ee
    s_mov_b32 s46, 0
    s_lshl_b32 s48, s42, 12
    v_mov_b32 v21, 4232
    v_mov_b32 v12, 0
    v_mov_b32 v13, 0
    v_mov_b32 v14, 0
    v_mov_b32 v15, 0
    v_mov_b32 v17, 0
    v_and_b32 v18, 1, v1
    v_lshlrev_b32 v18, 4, v18
    v_mov_b32 v16, 0xffff
    v_lshlrev_b32 v16, v18, v16
    v_bfe_u32 v18, v1, 1, 2
    v_cmp_eq_u32 vcc, 0, v18
    s_nop 1
    v_cndmask_b32 v8, 0, v16, vcc
    v_cmp_eq_u32 vcc, 1, v18
    s_nop 1
    v_cndmask_b32 v9, 0, v16, vcc
    v_cmp_eq_u32 vcc, 2, v18
    s_nop 1
    v_cndmask_b32 v10, 0, v16, vcc
    v_cmp_eq_u32 vcc, 3, v18
    s_nop 1
    v_cndmask_b32 v11, 0, v16, vcc
    v_mov_b32 v16, 0xff800000
    v_bfe_u32 v24, v1, 3, 1
    v_lshlrev_b32 v24, 6, v24
    s_lshl_b32 s44, s42, 10
    v_add_u32 v26, s44, v3
    s_lshl_b32 s44, s42, 3
    s_add_u32 s44, s44, 4096
    v_add_u32 v25, s44, v24
L_round0:
    ds_read_b32 v22, v21
    v_add_u32 v21, 4, v21
    s_mov_b32 s49, s46
    s_waitcnt lgkmcnt(0)
    v_readfirstlane_b32 s47, v22
    s_nop 3
    s_cmp_eq_u32 s47, -1
    s_cselect_b32 s46, 1, s46
    s_cselect_b32 s18, 0, s18
    s_cselect_b32 s22, 0, s22
    s_cselect_b32 s47, 0, s47
    s_add_u32 s47, s47, s48
    s_waitcnt vmcnt(15)
    v_mfma_f32_16x16x32_bf16 v[40:43], v[56:59], v[4:7], 0
    s_waitcnt vmcnt(14)
    v_mfma_f32_16x16x32_bf16 v[44:47], v[60:63], v[4:7], 0
    s_waitcnt vmcnt(13)
    v_mfma_f32_16x16x32_bf16 v[48:51], v[64:67], v[4:7], 0
    s_waitcnt vmcnt(12)
    v_mfma_f32_16x16x32_bf16 v[52:55], v[68:71], v[4:7], 0
    buffer_load_dwordx4 v[56:59], v2, s[16:19], s47 offen nt
    buffer_load_dwordx4 v[60:63], v2, s[16:19], s47 offen offset:1024 nt
    buffer_load_dwordx4 v[64:67], v2, s[16:19], s47 offen offset:2048 nt
    buffer_load_dwordx4 v[68:71], v2, s[16:19], s47 offen offset:3072 nt
    v_mov_b32_dpp v36, v40 quad_perm:[0,0,0,0] row_mask:0xf bank_mask:0xf
    v_add_f32_dpp v36, v41, v36 quad_perm:[1,1,1,1] row_mask:0xf bank_mask:0xf
    v_add_f32_dpp v36, v42, v36 quad_perm:[2,2,2,2] row_mask:0xf bank_mask:0xf
    v_add_f32_dpp v36, v43, v36 quad_perm:[3,3,3,3] row_mask:0xf bank_mask:0xf
    v_mov_b32_dpp v37, v44 quad_perm:[0,0,0,0] row_mask:0xf bank_mask:0xf
    v_add_f32_dpp v37, v45, v37 quad_perm:[1,1,1,1] row_mask:0xf bank_mask:0xf
    v_add_f32_dpp v37, v46, v37 quad_perm:[2,2,2,2] row_mask:0xf bank_mask:0xf
    v_add_f32_dpp v37, v47, v37 quad_perm:[3,3,3,3] row_mask:0xf bank_mask:0xf
    v_mov_b32_dpp v38, v48 quad_perm:[0,0,0,0] row_mask:0xf bank_mask:0xf
    v_add_f32_dpp v38, v49, v38 quad_perm:[1,1,1,1] row_mask:0xf bank_mask:0xf
    v_add_f32_dpp v38, v50, v38 quad_perm:[2,2,2,2] row_mask:0xf bank_mask:0xf
    v_add_f32_dpp v38, v51, v38 quad_perm:[3,3,3,3] row_mask:0xf bank_mask:0xf
    v_mov_b32_dpp v39, v52 quad_perm:[0,0,0,0] row_mask:0xf bank_mask:0xf
    v_add_f32_dpp v39, v53, v39 quad_perm:[1,1,1,1] row_mask:0xf bank_mask:0xf
    v_add_f32_dpp v39, v54, v39 quad_perm:[2,2,2,2] row_mask:0xf bank_mask:0xf
    v_add_f32_dpp v39, v55, v39 quad_perm:[3,3,3,3] row_mask:0xf bank_mask:0xf
    v_max_f32 v18, v36, v37
    v_max3_f32 v18, v18, v38, v39
    v_mov_b32 v19, v18
    s_nop 1
    v_permlane32_swap_b32 v18, v19
    s_nop 1
    v_max_f32 v18, v18, v19
    v_mov_b32 v19, v18
    s_nop 1
    v_permlane16_swap_b32 v18, v19
    s_nop 1
    v_max_f32 v18, v18, v19
    v_mul_f32 v18, s43, v18
    v_max_f32 v18, v18, v16
    v_sub_f32 v23, v16, v18
    v_mov_b32 v16, v18
    v_exp_f32 v23, v23
    v_fma_f32 v36, v36, s43, -v16
    v_fma_f32 v37, v37, s43, -v16
    v_fma_f32 v38, v38, s43, -v16
    v_fma_f32 v39, v39, s43, -v16
    v_exp_f32 v36, v36
    v_exp_f32 v37, v37
    v_exp_f32 v38, v38
    v_exp_f32 v39, v39
    v_mul_f32 v12, v12, v23
    v_mul_f32 v13, v13, v23
    v_mul_f32 v14, v14, v23
    v_mul_f32 v15, v15, v23
    v_fma_f32 v17, v17, v23, v36
    v_add_f32 v17, v17, v37
    v_add_f32 v17, v17, v38
    v_add_f32 v17, v17, v39
    v_cvt_pk_bf16_f32 v36, v36, v36
    v_cvt_pk_bf16_f32 v37, v37, v37
    v_cvt_pk_bf16_f32 v38, v38, v38
    v_cvt_pk_bf16_f32 v39, v39, v39
    v_and_b32 v28, v36, v8
    v_and_b32 v29, v36, v9
    v_and_b32 v30, v36, v10
    v_and_b32 v31, v36, v11
    v_and_b32 v32, v37, v8
    v_and_b32 v33, v37, v9
    v_and_b32 v34, v37, v10
    v_and_b32 v35, v37, v11
    s_waitcnt vmcnt(15)
    v_mfma_f32_16x16x32_bf16 v[12:15], v[72:75], v[28:31], v[12:15]
    v_and_b32 v28, v38, v8
    v_and_b32 v29, v38, v9
    v_and_b32 v30, v38, v10
    v_and_b32 v31, v38, v11
    s_waitcnt vmcnt(14)
    v_mfma_f32_16x16x32_bf16 v[12:15], v[76:79], v[32:35], v[12:15]
    v_and_b32 v32, v39, v8
    v_and_b32 v33, v39, v9
    v_and_b32 v34, v39, v10
    v_and_b32 v35, v39, v11
    s_waitcnt vmcnt(13)
    v_mfma_f32_16x16x32_bf16 v[12:15], v[80:83], v[28:31], v[12:15]
    s_cmp_lg_u32 s49, 0
    s_nop 0
    s_waitcnt vmcnt(12)
    v_mfma_f32_16x16x32_bf16 v[12:15], v[84:87], v[32:35], v[12:15]
    s_cbranch_scc1 L_fin
    buffer_load_dwordx4 v[72:75], v3, s[20:23], s47 offen nt
    buffer_load_dwordx4 v[76:79], v3, s[20:23], s47 offen offset:1024 nt
    buffer_load_dwordx4 v[80:83], v3, s[20:23], s47 offen offset:2048 nt
    buffer_load_dwordx4 v[84:87], v3, s[20:23], s47 offen offset:3072 nt
    s_barrier
L_round1:
    ds_read_b32 v22, v21
    v_add_u32 v21, 4, v21
    s_mov_b32 s49, s46
    s_waitcnt lgkmcnt(0)
    v_readfirstlane_b32 s47, v22
    s_nop 3
    s_cmp_eq_u32 s47, -1
    s_cselect_b32 s46, 1, s46
    s_cselect_b32 s18, 0, s18
    s_cselect_b32 s22, 0, s22
    s_cselect_b32 s47, 0, s47
    s_add_u32 s47, s47, s48
    s_waitcnt vmcnt(15)
    v_mfma_f32_16x16x32_bf16 v[40:43], v[88:91], v[4:7], 0
    s_waitcnt vmcnt(14)
    v_mfma_f32_16x16x32_bf16 v[44:47], v[92:95], v[4:7], 0
    s_waitcnt vmcnt(13)
    v_mfma_f32_16x16x32_bf16 v[48:51], v[96:99], v[4:7], 0
    s_waitcnt vmcnt(12)
    v_mfma_f32_16x16x32_bf16 v[52:55], v[100:103], v[4:7], 0
    buffer_load_dwordx4 v[88:91], v2, s[16:19], s47 offen nt
    buffer_load_dwordx4 v[92:95], v2, s[16:19], s47 offen offset:1024 nt
    buffer_load_dwordx4 v[96:99], v2, s[16:19], s47 offen offset:2048 nt
    buffer_load_dwordx4 v[100:103], v2, s[16:19], s47 offen offset:3072 nt
    v_mov_b32_dpp v36, v40 quad_perm:[0,0,0,0] row_mask:0xf bank_mask:0xf
    v_add_f32_dpp v36, v41, v36 quad_perm:[1,1,1,1] row_mask:0xf bank_mask:0xf
    v_add_f32_dpp v36, v42, v36 quad_perm:[2,2,2,2] row_mask:0xf bank_mask:0xf
    v_add_f32_dpp v36, v43, v36 quad_perm:[3,3,3,3] row_mask:0xf bank_mask:0xf
    v_mov_b32_dpp v37, v44 quad_perm:[0,0,0,0] row_mask:0xf bank_mask:0xf
    v_add_f32_dpp v37, v45, v37 quad_perm:[1,1,1,1] row_mask:0xf bank_mask:0xf
    v_add_f32_dpp v37, v46, v37 quad_perm:[2,2,2,2] row_mask:0xf bank_mask:0xf
    v_add_f32_dpp v37, v47, v37 quad_perm:[3,3,3,3] row_mask:0xf bank_mask:0xf
    v_mov_b32_dpp v38, v48 quad_perm:[0,0,0,0] row_mask:0xf bank_mask:0xf
    v_add_f32_dpp v38, v49, v38 quad_perm:[1,1,1,1] row_mask:0xf bank_mask:0xf
    v_add_f32_dpp v38, v50, v38 quad_perm:[2,2,2,2] row_mask:0xf bank_mask:0xf
    v_add_f32_dpp v38, v51, v38 quad_perm:[3,3,3,3] row_mask:0xf bank_mask:0xf
    v_mov_b32_dpp v39, v52 quad_perm:[0,0,0,0] row_mask:0xf bank_mask:0xf
    v_add_f32_dpp v39, v53, v39 quad_perm:[1,1,1,1] row_mask:0xf bank_mask:0xf
    v_add_f32_dpp v39, v54, v39 quad_perm:[2,2,2,2] row_mask:0xf bank_mask:0xf
    v_add_f32_dpp v39, v55, v39 quad_perm:[3,3,3,3] row_mask:0xf bank_mask:0xf
    v_max_f32 v18, v36, v37
    v_max3_f32 v18, v18, v38, v39
    v_mov_b32 v19, v18
    s_nop 1
    v_permlane32_swap_b32 v18, v19
    s_nop 1
    v_max_f32 v18, v18, v19
    v_mov_b32 v19, v18
    s_nop 1
    v_permlane16_swap_b32 v18, v19
    s_nop 1
    v_max_f32 v18, v18, v19
    v_mul_f32 v18, s43, v18
    v_max_f32 v18, v18, v16
    v_sub_f32 v23, v16, v18
    v_mov_b32 v16, v18
    v_exp_f32 v23, v23
    v_fma_f32 v36, v36, s43, -v16
    v_fma_f32 v37, v37, s43, -v16
    v_fma_f32 v38, v38, s43, -v16
    v_fma_f32 v39, v39, s43, -v16
    v_exp_f32 v36, v36
    v_exp_f32 v37, v37
    v_exp_f32 v38, v38
    v_exp_f32 v39, v39
    v_mul_f32 v12, v12, v23
    v_mul_f32 v13, v13, v23
    v_mul_f32 v14, v14, v23
    v_mul_f32 v15, v15, v23
    v_fma_f32 v17, v17, v23, v36
    v_add_f32 v17, v17, v37
    v_add_f32 v17, v17, v38
    v_add_f32 v17, v17, v39
    v_cvt_pk_bf16_f32 v36, v36, v36
    v_cvt_pk_bf16_f32 v37, v37, v37
    v_cvt_pk_bf16_f32 v38, v38, v38
    v_cvt_pk_bf16_f32 v39, v39, v39
    v_and_b32 v28, v36, v8
    v_and_b32 v29, v36, v9
    v_and_b32 v30, v36, v10
    v_and_b32 v31, v36, v11
    v_and_b32 v32, v37, v8
    v_and_b32 v33, v37, v9
    v_and_b32 v34, v37, v10
    v_and_b32 v35, v37, v11
    s_waitcnt vmcnt(15)
    v_mfma_f32_16x16x32_bf16 v[12:15], v[104:107], v[28:31], v[12:15]
    v_and_b32 v28, v38, v8
    v_and_b32 v29, v38, v9
    v_and_b32 v30, v38, v10
    v_and_b32 v31, v38, v11
    s_waitcnt vmcnt(14)
    v_mfma_f32_16x16x32_bf16 v[12:15], v[108:111], v[32:35], v[12:15]
    v_and_b32 v32, v39, v8
    v_and_b32 v33, v39, v9
    v_and_b32 v34, v39, v10
    v_and_b32 v35, v39, v11
    s_waitcnt vmcnt(13)
    v_mfma_f32_16x16x32_bf16 v[12:15], v[112:115], v[28:31], v[12:15]
    s_cmp_lg_u32 s49, 0
    s_nop 0
    s_waitcnt vmcnt(12)
    v_mfma_f32_16x16x32_bf16 v[12:15], v[116:119], v[32:35], v[12:15]
    s_cbranch_scc1 L_fin
    buffer_load_dwordx4 v[104:107], v3, s[20:23], s47 offen nt
    buffer_load_dwordx4 v[108:111], v3, s[20:23], s47 offen offset:1024 nt
    buffer_load_dwordx4 v[112:115], v3, s[20:23], s47 offen offset:2048 nt
    buffer_load_dwordx4 v[116:119], v3, s[20:23], s47 offen offset:3072 nt
    s_barrier
    s_branch L_round0
L_fin:
    v_mov_b32 v19, v17
    s_nop 1
    v_permlane32_swap_b32 v17, v19
    s_nop 1
    v_add_f32 v17, v17, v19
    v_mov_b32 v19, v17
    s_nop 1
    v_permlane16_swap_b32 v17, v19
    ds_write_b128 v26, v[12:15]
    s_nop 0
    v_add_f32 v17, v17, v19
    ds_write_b64 v25, v[16:17]
    s_waitcnt lgkmcnt(0)
    s_barrier
    s_endpgm
L_helper:
    v_lshl_add_u32 v18, v1, 2, s41
    v_lshlrev_b32 v18, 14, v18
    s_lshl_b32 s47, s40, 20
    v_add_u32 v18, s47, v18
    v_cmp_gt_u32 vcc, 12, v1
    v_lshlrev_b32 v19, 2, v1
    v_add_u32 v19, 4224, v19
    v_cndmask_b32 v18, -1, v18, vcc
    ds_write_b32 v19, v18
    s_waitcnt lgkmcnt(0)
    s_barrier
    s_mov_b32 s30, 0x8000
    s_mov_b32 s31, 0x20000
    s_mov_b32 s34, 0x100000
    s_mov_b32 s35, 0x20000
    s_mov_b32 s38, 256
    s_mov_b32 s39, 0x20000
    s_lshl_b32 s44, s40, 13
    s_add_u32 s45, s41, 0
    s_and_b32 s45, s45, 3
    s_lshl_b32 s45, s45, 11
    s_add_u32 s52, s44, s45
    s_add_u32 s45, s41, 1
    s_and_b32 s45, s45, 3
    s_lshl_b32 s45, s45, 11
    s_add_u32 s53, s44, s45
    s_add_u32 s45, s41, 2
    s_and_b32 s45, s45, 3
    s_lshl_b32 s45, s45, 11
    s_add_u32 s54, s44, s45
    s_add_u32 s45, s41, 3
    s_and_b32 s45, s45, 3
    s_lshl_b32 s45, s45, 11
    s_add_u32 s55, s44, s45
    s_lshl_b32 s44, s40, 8
    s_add_u32 s44, s44, 0x80000
    v_lshlrev_b32 v4, 24, v1
    v_add_u32 v4, s44, v4
    v_mov_b32 v5, 0
    s_cmp_lg_u32 s41, 0
    s_cbranch_scc1 L_noz
    buffer_store_dword v5, v4, s[32:35], 0 offen sc1
L_noz:
    v_mov_b32 v28, -1
    v_mov_b32 v29, -1
    v_mov_b32 v30, -1
    v_mov_b32 v31, -1
    v_and_b32 v7, 8, v1
    v_add_u32 v7, 0x400, v7
    v_and_b32 v8, 0x37, v1
    v_lshl_add_u32 v8, v8, 24, v7
    buffer_store_dwordx4 v[28:31], v3, s[32:35], s52 offen sc1
    buffer_store_dwordx2 v[28:29], v8, s[32:35], s52 offen sc1
    v_bfe_u32 v18, v1, 3, 1
    v_lshlrev_b32 v24, 6, v18
    v_add_u32 v24, 4096, v24
    s_lshl_b32 s44, s40, 2
    v_lshlrev_b32 v21, 12, v1
    v_add_u32 v21, s44, v21
    v_lshlrev_b32 v27, 8, v18
    v_lshrrev_b32 v18, 4, v1
    v_lshl_add_u32 v27, v18, 6, v27
    v_and_b32 v18, 7, v1
    v_lshl_add_u32 v27, v18, 1, v27
    s_lshl_b32 s44, s40, 9
    v_add_u32 v27, s44, v27
    s_lshl_b32 s44, s40, 2
    v_mov_b32 v22, s44
    v_mov_b32 v6, 4272
    s_add_u32 s47, s47, 786432
    s_barrier
    s_barrier
    v_mov_b32 v20, 0x100
    s_cmp_eq_u32 s41, 0
    s_cselect_b32 s44, 0x101, 1
    v_mov_b32 v23, s44
    s_waitcnt vmcnt(0)
    buffer_atomic_add v23, v21, s[36:39], 0 offen sc0
    s_barrier
    s_barrier
    s_barrier
    s_barrier
    s_barrier
    s_cmp_eq_u32 s41, 0
    s_cbranch_scc1 L_nol
    buffer_load_dword v20, v22, s[36:39], 0 offen sc1
L_nol:
    s_mov_b32 s70, 8
    s_barrier
    s_waitcnt vmcnt(0)
    v_readfirstlane_b32 s44, v20
    v_readfirstlane_b32 s51, v23
    s_nop 3
    s_and_b32 s51, s51, 0xff
L_fchk:
    s_lshr_b32 s44, s44, 8
    s_cmp_lg_u32 s44, 0
    s_cbranch_scc1 L_claim
    s_sub_u32 s70, s70, 1
    s_cmp_eq_u32 s70, 0
    s_cbranch_scc1 L_stop0
    buffer_load_dword v20, v22, s[36:39], 0 offen sc1
    s_waitcnt vmcnt(0)
    v_readfirstlane_b32 s44, v20
    s_nop 3
    s_branch L_fchk
L_claim:
    v_mov_b32 v5, 1
    buffer_atomic_add v5, v4, s[32:35], 0 offen sc0
    s_waitcnt lgkmcnt(0)
    s_barrier
    s_waitcnt vmcnt(0)
    v_readfirstlane_b32 s44, v5
    s_nop 3
    s_cmp_ge_u32 s44, 16
    s_cbranch_scc1 L_stop
    s_lshl_b32 s44, s44, 14
    s_add_u32 s44, s44, s47
    v_mov_b32 v19, s44
    ds_write_b32 v6, v19
    v_add_u32 v6, 4, v6
    s_branch L_claim
L_stop0:
    s_barrier
L_stop:
    s_barrier
    s_barrier
    s_cmp_lg_u32 s51, 3
    s_cbranch_scc1 L_noA
    buffer_load_dwordx2 v[64:65], v7, s[32:35], s53 offen sc1
    buffer_load_dwordx2 v[72:73], v7, s[32:35], s54 offen sc1
    buffer_load_dwordx2 v[80:81], v7, s[32:35], s55 offen sc1
    buffer_load_dwordx4 v[60:63], v3, s[32:35], s53 offen sc1
    buffer_load_dwordx4 v[68:71], v3, s[32:35], s54 offen sc1
    buffer_load_dwordx4 v[76:79], v3, s[32:35], s55 offen sc1
L_noA:
    s_barrier
    ds_read_b128 v[84:87], v24 offset:0
    ds_read_b128 v[88:91], v24 offset:16
    ds_read_b128 v[100:103], v3
    ds_read_b128 v[104:107], v3 offset:1024
    ds_read_b128 v[108:111], v3 offset:2048
    ds_read_b128 v[112:115], v3 offset:3072
    s_cmp_lg_u32 s51, 3
    s_cbranch_scc1 L_noB
    buffer_load_dwordx2 v[40:41], v7, s[32:35], s53 offen sc1
    buffer_load_dwordx2 v[48:49], v7, s[32:35], s54 offen sc1
    buffer_load_dwordx2 v[56:57], v7, s[32:35], s55 offen sc1
    buffer_load_dwordx4 v[36:39], v3, s[32:35], s53 offen sc1
    buffer_load_dwordx4 v[44:47], v3, s[32:35], s54 offen sc1
    buffer_load_dwordx4 v[52:55], v3, s[32:35], s55 offen sc1
L_noB:
    s_waitcnt lgkmcnt(4)
    v_max_f32 v32, v84, v86
    v_max3_f32 v32, v32, v88, v90
    v_sub_f32 v84, v84, v32
    v_sub_f32 v86, v86, v32
    v_sub_f32 v88, v88, v32
    v_sub_f32 v90, v90, v32
    v_exp_f32 v84, v84
    v_exp_f32 v86, v86
    v_exp_f32 v88, v88
    v_exp_f32 v90, v90
    s_nop 0
    v_mul_f32 v33, v84, v85
    v_fmac_f32 v33, v86, v87
    v_fmac_f32 v33, v88, v89
    v_fmac_f32 v33, v90, v91
    v_min_u32 v33, -2, v33
    s_waitcnt lgkmcnt(3)
    v_mul_f32 v28, v100, v84
    v_mul_f32 v29, v101, v84
    v_mul_f32 v30, v102, v84
    v_mul_f32 v31, v103, v84
    s_waitcnt lgkmcnt(2)
    v_fmac_f32 v28, v104, v86
    v_fmac_f32 v29, v105, v86
    v_fmac_f32 v30, v106, v86
    v_fmac_f32 v31, v107, v86
    s_waitcnt lgkmcnt(1)
    v_fmac_f32 v28, v108, v88
    v_fmac_f32 v29, v109, v88
    v_fmac_f32 v30, v110, v88
    v_fmac_f32 v31, v111, v88
    s_waitcnt lgkmcnt(0)
    v_fmac_f32 v28, v112, v90
    v_fmac_f32 v29, v113, v90
    v_fmac_f32 v30, v114, v90
    v_fmac_f32 v31, v115, v90
    s_cmp_eq_u32 s51, 3
    v_min_u32 v28, -2, v28
    s_cbranch_scc1 L_F
    buffer_store_dwordx4 v[28:31], v3, s[32:35], s52 offen sc1
    buffer_store_dwordx2 v[32:33], v8, s[32:35], s52 offen sc1
    s_endpgm
L_F:
    s_mov_b32 s70, 0x100000
L_poll:
    s_waitcnt vmcnt(6)
    v_max3_u32 v18, v60, v65, v68
    v_max3_u32 v18, v18, v73, v76
    v_max_u32 v18, v18, v81
    v_cmp_eq_u32 vcc, -1, v18
    s_nop 3
    s_cmp_eq_u64 vcc, 0
    s_cbranch_scc1 L_waitst
    buffer_load_dwordx2 v[64:65], v7, s[32:35], s53 offen sc1
    buffer_load_dwordx2 v[72:73], v7, s[32:35], s54 offen sc1
    buffer_load_dwordx2 v[80:81], v7, s[32:35], s55 offen sc1
    buffer_load_dwordx4 v[60:63], v3, s[32:35], s53 offen sc1
    buffer_load_dwordx4 v[68:71], v3, s[32:35], s54 offen sc1
    buffer_load_dwordx4 v[76:79], v3, s[32:35], s55 offen sc1
    s_waitcnt vmcnt(6)
    v_max3_u32 v18, v36, v41, v44
    v_max3_u32 v18, v18, v49, v52
    v_max_u32 v18, v18, v57
    v_cmp_eq_u32 vcc, -1, v18
    s_nop 3
    s_cmp_eq_u64 vcc, 0
    s_cbranch_scc1 L_final
    buffer_load_dwordx2 v[40:41], v7, s[32:35], s53 offen sc1
    buffer_load_dwordx2 v[48:49], v7, s[32:35], s54 offen sc1
    buffer_load_dwordx2 v[56:57], v7, s[32:35], s55 offen sc1
    buffer_load_dwordx4 v[36:39], v3, s[32:35], s53 offen sc1
    buffer_load_dwordx4 v[44:47], v3, s[32:35], s54 offen sc1
    buffer_load_dwordx4 v[52:55], v3, s[32:35], s55 offen sc1
    s_sub_u32 s70, s70, 1
    s_cmp_lg_u32 s70, 0
    s_cbranch_scc1 L_poll
    s_waitcnt vmcnt(0)
L_final:
    v_max_f32 v18, v32, v40
    v_max3_f32 v18, v18, v48, v56
    v_sub_f32 v84, v32, v18
    v_sub_f32 v86, v40, v18
    v_sub_f32 v88, v48, v18
    v_sub_f32 v90, v56, v18
    v_exp_f32 v84, v84
    v_exp_f32 v86, v86
    v_exp_f32 v88, v88
    v_exp_f32 v90, v90
    s_nop 0
    v_mul_f32 v19, v33, v84
    v_fmac_f32 v19, v41, v86
    v_fmac_f32 v19, v49, v88
    v_fmac_f32 v19, v57, v90
    v_rcp_f32 v18, v19
    v_pk_mul_f32 v[28:29], v[28:29], v[84:85] op_sel_hi:[1,0]
    v_pk_mul_f32 v[30:31], v[30:31], v[84:85] op_sel_hi:[1,0]
    v_pk_fma_f32 v[28:29], v[36:37], v[86:87], v[28:29] op_sel_hi:[1,0,1]
    v_pk_fma_f32 v[30:31], v[38:39], v[86:87], v[30:31] op_sel_hi:[1,0,1]
    v_pk_fma_f32 v[28:29], v[44:45], v[88:89], v[28:29] op_sel_hi:[1,0,1]
    v_pk_fma_f32 v[30:31], v[46:47], v[88:89], v[30:31] op_sel_hi:[1,0,1]
    v_pk_fma_f32 v[28:29], v[52:53], v[90:91], v[28:29] op_sel_hi:[1,0,1]
    v_pk_fma_f32 v[30:31], v[54:55], v[90:91], v[30:31] op_sel_hi:[1,0,1]
    v_pk_mul_f32 v[28:29], v[28:29], v[18:19] op_sel_hi:[1,0]
    v_pk_mul_f32 v[30:31], v[30:31], v[18:19] op_sel_hi:[1,0]
    v_cvt_pk_bf16_f32 v28, v28, v29
    v_cvt_pk_bf16_f32 v30, v30, v31
    buffer_store_short v28, v27, s[28:31], 0 offen
    buffer_store_short_d16_hi v28, v27, s[28:31], 0 offen offset:16
    buffer_store_short v30, v27, s[28:31], 0 offen offset:32
    buffer_store_short_d16_hi v30, v27, s[28:31], 0 offen offset:48
    s_branch L_done
L_waitst:
L_finalA:
    v_max_f32 v18, v32, v64
    v_max3_f32 v18, v18, v72, v80
    v_sub_f32 v84, v32, v18
    v_sub_f32 v86, v64, v18
    v_sub_f32 v88, v72, v18
    v_sub_f32 v90, v80, v18
    v_exp_f32 v84, v84
    v_exp_f32 v86, v86
    v_exp_f32 v88, v88
    v_exp_f32 v90, v90
    s_nop 0
    v_mul_f32 v19, v33, v84
    v_fmac_f32 v19, v65, v86
    v_fmac_f32 v19, v73, v88
    v_fmac_f32 v19, v81, v90
    v_rcp_f32 v18, v19
    v_pk_mul_f32 v[28:29], v[28:29], v[84:85] op_sel_hi:[1,0]
    v_pk_mul_f32 v[30:31], v[30:31], v[84:85] op_sel_hi:[1,0]
    v_pk_fma_f32 v[28:29], v[60:61], v[86:87], v[28:29] op_sel_hi:[1,0,1]
    v_pk_fma_f32 v[30:31], v[62:63], v[86:87], v[30:31] op_sel_hi:[1,0,1]
    v_pk_fma_f32 v[28:29], v[68:69], v[88:89], v[28:29] op_sel_hi:[1,0,1]
    v_pk_fma_f32 v[30:31], v[70:71], v[88:89], v[30:31] op_sel_hi:[1,0,1]
    v_pk_fma_f32 v[28:29], v[76:77], v[90:91], v[28:29] op_sel_hi:[1,0,1]
    v_pk_fma_f32 v[30:31], v[78:79], v[90:91], v[30:31] op_sel_hi:[1,0,1]
    v_pk_mul_f32 v[28:29], v[28:29], v[18:19] op_sel_hi:[1,0]
    v_pk_mul_f32 v[30:31], v[30:31], v[18:19] op_sel_hi:[1,0]
    v_cvt_pk_bf16_f32 v28, v28, v29
    v_cvt_pk_bf16_f32 v30, v30, v31
    buffer_store_short v28, v27, s[28:31], 0 offen
    buffer_store_short_d16_hi v28, v27, s[28:31], 0 offen offset:16
    buffer_store_short v30, v27, s[28:31], 0 offen offset:32
    buffer_store_short_d16_hi v30, v27, s[28:31], 0 offen offset:48
L_done:
L_end:
    s_endpgm
.section .rodata,"a"
.p2align 6
.amdhsa_kernel standalone__gqa_softmax__decode_kernel
  .amdhsa_next_free_vgpr 136
  .amdhsa_next_free_sgpr 96
  .amdhsa_accum_offset 136
  .amdhsa_group_segment_fixed_size 0
  .amdhsa_kernarg_size 48
  .amdhsa_user_sgpr_count 2
  .amdhsa_user_sgpr_kernarg_segment_ptr 1
  .amdhsa_system_sgpr_workgroup_id_x 1
.end_amdhsa_kernel
```
